```python
import torch

def _softmax(x, axis=-1):
    return torch.softmax(x, dim=axis)
def _gelu(x):
    return torch.nn.functional.gelu(x, approximate="tanh")
def _silu(x):
    return torch.nn.functional.silu(x)
def _sigmoid(x):
    return torch.sigmoid(x)
def _layernorm(x, axis=-1, eps=1e-5):
    m = x.mean(dim=axis, keepdim=True)
    v = x.var(dim=axis, keepdim=True, unbiased=False)
    return (x - m) / torch.sqrt(v + eps)
def _scatter_add(tgt, idx, src, axis=0):
    return tgt.clone().index_add_(axis, idx, src)
def _segment_sum(src, seg, n):
    out = torch.zeros((n,) + src.shape[1:], dtype=src.dtype)
    return out.index_add_(0, seg, src)
def _pad(x, pw):
    flat = tuple(v for pair in reversed(pw) for v in pair)
    return torch.nn.functional.pad(x, flat)

kernel_name = 'standalone__grn__sampling'

def setup_inputs():

    _w = (lambda a: (lambda t: t.to(torch.bfloat16) if t.is_floating_point() else t)(torch.as_tensor(a)))
    B, S, D = 1024, 16, 512
    return {
        "x": _w((lambda *s: torch.randn(*s, dtype=torch.bfloat16) * 0.05)(B, S, D)),
        "g": _w((lambda *s: torch.randn(*s, dtype=torch.bfloat16) * 0.4)(D) * 0.1),
        "b": _w((lambda *s: torch.randn(*s, dtype=torch.bfloat16) * 0.1)(D) * 0.1),
    }

def reference(x, g, b):
    gx = torch.sqrt((x * x).sum(axis=-2, keepdims=True))
    nx = gx / (gx.mean(axis=-1, keepdims=True) + 1e-6)
    return g * (x * nx) + b + x
```

```asm
; @launch grid=(1024,1,1) block=(64,1,1) lds=0
.amdgcn_target "amdgcn-amd-amdhsa--gfx950"
.text
.p2align 12
.globl standalone__grn__sampling_kernel
.p2align 8
.type standalone__grn__sampling_kernel,@function
standalone__grn__sampling_kernel:
    s_load_dwordx8 s[4:11], s[0:1], 0
    s_cmp_ge_u32 s2, 1024
    s_cbranch_scc1 L_done
    v_lshlrev_b32 v1, 4, v0
    s_lshl_b32 s3, s2, 14
    s_and_b32 s13, s2, 0x80
    s_lshl_b32 s13, s13, 12
    s_xor_b32 s3, s3, s13
    s_and_b32 s13, s2, 0x300
    s_lshl_b32 s13, s13, 7
    s_xor_b32 s3, s3, s13
    s_and_b32 s13, s2, 0x1
    s_lshl_b32 s13, s13, 22
    s_xor_b32 s3, s3, s13
    s_and_b32 s13, s2, 0x8
    s_lshl_b32 s13, s13, 20
    s_xor_b32 s3, s3, s13
    s_and_b32 s13, s2, 0x40
    s_lshl_b32 s13, s13, 8
    s_xor_b32 s3, s3, s13
    v_or_b32 v168, s3, v1
    v_or_b32 v169, 0x1000, v168
    v_or_b32 v170, 0x2000, v168
    v_or_b32 v171, 0x3000, v168
    s_mov_b32 s12, 0xffff0000
    v_mov_b32 v4, 0x3b000000
    v_mov_b32 v5, 0x358637bd
    s_lshr_b32 s13, s2, 8
    s_cmp_eq_u32 s13, 2
    s_cbranch_scc1 H1
    s_cmp_eq_u32 s13, 3
    s_cbranch_scc1 H2
Hback:
    s_cmp_lg_u32 s2, s2
    s_waitcnt lgkmcnt(0)
    global_load_dwordx4 v[8:11], v168, s[4:5] offset:0 nt
    global_load_dwordx4 v[12:15], v168, s[4:5] offset:1024 nt
    global_load_dwordx4 v[16:19], v168, s[4:5] offset:2048 nt
    global_load_dwordx4 v[20:23], v168, s[4:5] offset:3072 nt
    global_load_dwordx4 v[24:27], v169, s[4:5] offset:0 nt
    global_load_dwordx4 v[28:31], v169, s[4:5] offset:1024 nt
    global_load_dwordx4 v[32:35], v169, s[4:5] offset:2048 nt
    global_load_dwordx4 v[36:39], v169, s[4:5] offset:3072 nt
    global_load_dwordx4 v[40:43], v170, s[4:5] offset:0 nt
    global_load_dwordx4 v[160:163], v1, s[6:7]
    global_load_dwordx4 v[164:167], v1, s[8:9]
    global_load_dwordx4 v[44:47], v170, s[4:5] offset:1024 nt
    global_load_dwordx4 v[48:51], v170, s[4:5] offset:2048 nt
    global_load_dwordx4 v[52:55], v170, s[4:5] offset:3072 nt
    global_load_dwordx4 v[56:59], v171, s[4:5] offset:0 nt
    global_load_dwordx4 v[60:63], v171, s[4:5] offset:1024 nt
    global_load_dwordx4 v[64:67], v171, s[4:5] offset:2048 nt
    global_load_dwordx4 v[68:71], v171, s[4:5] offset:3072 nt
    s_waitcnt vmcnt(17)
    v_lshlrev_b32 v72, 16, v8
    v_and_b32 v8, s12, v8
    v_lshlrev_b32 v73, 16, v9
    v_and_b32 v9, s12, v9
    v_lshlrev_b32 v74, 16, v10
    v_and_b32 v10, s12, v10
    v_lshlrev_b32 v75, 16, v11
    v_and_b32_e64 v11, s12, v11
    v_pk_mul_f32 v[136:137], v[8:9], v[8:9]
    v_pk_mul_f32 v[140:141], v[72:73], v[72:73]
    v_pk_mul_f32 v[138:139], v[10:11], v[10:11]
    v_pk_mul_f32 v[142:143], v[74:75], v[74:75]
    s_waitcnt vmcnt(16)
    v_lshlrev_b32 v76, 16, v12
    v_and_b32 v12, s12, v12
    v_lshlrev_b32 v77, 16, v13
    v_and_b32 v13, s12, v13
    v_lshlrev_b32 v78, 16, v14
    v_and_b32 v14, s12, v14
    v_lshlrev_b32 v79, 16, v15
    v_and_b32_e64 v15, s12, v15
    v_pk_fma_f32 v[136:137], v[12:13], v[12:13], v[136:137]
    v_pk_fma_f32 v[140:141], v[76:77], v[76:77], v[140:141]
    v_pk_fma_f32 v[138:139], v[14:15], v[14:15], v[138:139]
    v_pk_fma_f32 v[142:143], v[78:79], v[78:79], v[142:143]
    s_waitcnt vmcnt(15)
    v_lshlrev_b32 v80, 16, v16
    v_and_b32 v16, s12, v16
    v_lshlrev_b32 v81, 16, v17
    v_and_b32 v17, s12, v17
    v_lshlrev_b32 v82, 16, v18
    v_and_b32 v18, s12, v18
    v_lshlrev_b32 v83, 16, v19
    v_and_b32_e64 v19, s12, v19
    v_pk_fma_f32 v[136:137], v[16:17], v[16:17], v[136:137]
    v_pk_fma_f32 v[140:141], v[80:81], v[80:81], v[140:141]
    v_pk_fma_f32 v[138:139], v[18:19], v[18:19], v[138:139]
    v_pk_fma_f32 v[142:143], v[82:83], v[82:83], v[142:143]
    s_waitcnt vmcnt(14)
    v_lshlrev_b32 v84, 16, v20
    v_and_b32 v20, s12, v20
    v_lshlrev_b32 v85, 16, v21
    v_and_b32 v21, s12, v21
    v_lshlrev_b32 v86, 16, v22
    v_and_b32 v22, s12, v22
    v_lshlrev_b32 v87, 16, v23
    v_and_b32_e64 v23, s12, v23
    v_pk_fma_f32 v[136:137], v[20:21], v[20:21], v[136:137]
    v_pk_fma_f32 v[140:141], v[84:85], v[84:85], v[140:141]
    v_pk_fma_f32 v[138:139], v[22:23], v[22:23], v[138:139]
    v_pk_fma_f32 v[142:143], v[86:87], v[86:87], v[142:143]
    s_waitcnt vmcnt(13)
    v_lshlrev_b32 v88, 16, v24
    v_and_b32 v24, s12, v24
    v_lshlrev_b32 v89, 16, v25
    v_and_b32 v25, s12, v25
    v_lshlrev_b32 v90, 16, v26
    v_and_b32 v26, s12, v26
    v_lshlrev_b32 v91, 16, v27
    v_and_b32_e64 v27, s12, v27
    v_pk_fma_f32 v[136:137], v[24:25], v[24:25], v[136:137]
    v_pk_fma_f32 v[140:141], v[88:89], v[88:89], v[140:141]
    v_pk_fma_f32 v[138:139], v[26:27], v[26:27], v[138:139]
    v_pk_fma_f32 v[142:143], v[90:91], v[90:91], v[142:143]
    s_waitcnt vmcnt(12)
    v_lshlrev_b32 v92, 16, v28
    v_and_b32 v28, s12, v28
    v_lshlrev_b32 v93, 16, v29
    v_and_b32 v29, s12, v29
    v_lshlrev_b32 v94, 16, v30
    v_and_b32 v30, s12, v30
    v_lshlrev_b32 v95, 16, v31
    v_and_b32_e64 v31, s12, v31
    v_pk_fma_f32 v[136:137], v[28:29], v[28:29], v[136:137]
    v_pk_fma_f32 v[140:141], v[92:93], v[92:93], v[140:141]
    v_pk_fma_f32 v[138:139], v[30:31], v[30:31], v[138:139]
    v_pk_fma_f32 v[142:143], v[94:95], v[94:95], v[142:143]
    s_waitcnt vmcnt(11)
    v_lshlrev_b32 v96, 16, v32
    v_and_b32 v32, s12, v32
    v_lshlrev_b32 v97, 16, v33
    v_and_b32 v33, s12, v33
    v_lshlrev_b32 v98, 16, v34
    v_and_b32 v34, s12, v34
    v_lshlrev_b32 v99, 16, v35
    v_and_b32_e64 v35, s12, v35
    v_pk_fma_f32 v[136:137], v[32:33], v[32:33], v[136:137]
    v_pk_fma_f32 v[140:141], v[96:97], v[96:97], v[140:141]
    v_pk_fma_f32 v[138:139], v[34:35], v[34:35], v[138:139]
    v_pk_fma_f32 v[142:143], v[98:99], v[98:99], v[142:143]
    s_waitcnt vmcnt(10)
    v_lshlrev_b32 v100, 16, v36
    v_and_b32 v36, s12, v36
    v_lshlrev_b32 v101, 16, v37
    v_and_b32 v37, s12, v37
    v_lshlrev_b32 v102, 16, v38
    v_and_b32 v38, s12, v38
    v_lshlrev_b32 v103, 16, v39
    v_and_b32_e64 v39, s12, v39
    v_pk_fma_f32 v[136:137], v[36:37], v[36:37], v[136:137]
    v_pk_fma_f32 v[140:141], v[100:101], v[100:101], v[140:141]
    v_pk_fma_f32 v[138:139], v[38:39], v[38:39], v[138:139]
    v_pk_fma_f32 v[142:143], v[102:103], v[102:103], v[142:143]
    s_waitcnt vmcnt(9)
    v_lshlrev_b32 v104, 16, v40
    v_and_b32 v40, s12, v40
    v_lshlrev_b32 v105, 16, v41
    v_and_b32 v41, s12, v41
    v_lshlrev_b32 v106, 16, v42
    v_and_b32 v42, s12, v42
    v_lshlrev_b32 v107, 16, v43
    v_and_b32_e64 v43, s12, v43
    v_pk_fma_f32 v[136:137], v[40:41], v[40:41], v[136:137]
    v_pk_fma_f32 v[140:141], v[104:105], v[104:105], v[140:141]
    v_pk_fma_f32 v[138:139], v[42:43], v[42:43], v[138:139]
    v_pk_fma_f32 v[142:143], v[106:107], v[106:107], v[142:143]
    s_waitcnt vmcnt(7)
    v_lshlrev_b32 v148, 16, v160
    v_and_b32 v144, s12, v160
    v_lshlrev_b32 v149, 16, v161
    v_and_b32 v145, s12, v161
    v_lshlrev_b32 v150, 16, v162
    v_and_b32 v146, s12, v162
    v_lshlrev_b32 v151, 16, v163
    v_and_b32 v147, s12, v163
    v_lshlrev_b32 v156, 16, v164
    v_and_b32 v152, s12, v164
    v_lshlrev_b32 v157, 16, v165
    v_and_b32 v153, s12, v165
    v_lshlrev_b32 v158, 16, v166
    v_and_b32 v154, s12, v166
    v_lshlrev_b32 v159, 16, v167
    v_and_b32 v155, s12, v167
    s_waitcnt vmcnt(6)
    v_lshlrev_b32 v108, 16, v44
    v_and_b32 v44, s12, v44
    v_lshlrev_b32 v109, 16, v45
    v_and_b32 v45, s12, v45
    v_lshlrev_b32 v110, 16, v46
    v_and_b32 v46, s12, v46
    v_lshlrev_b32 v111, 16, v47
    v_and_b32 v47, s12, v47
    v_pk_fma_f32 v[136:137], v[44:45], v[44:45], v[136:137]
    v_pk_fma_f32 v[140:141], v[108:109], v[108:109], v[140:141]
    v_pk_fma_f32 v[138:139], v[46:47], v[46:47], v[138:139]
    v_pk_fma_f32 v[142:143], v[110:111], v[110:111], v[142:143]
H1:
    s_cbranch_scc1 Hback
    s_waitcnt vmcnt(5)
    v_lshlrev_b32 v112, 16, v48
    v_and_b32 v48, s12, v48
    v_lshlrev_b32 v113, 16, v49
    v_and_b32 v49, s12, v49
    v_lshlrev_b32 v114, 16, v50
    v_and_b32 v50, s12, v50
    v_lshlrev_b32 v115, 16, v51
    v_and_b32 v51, s12, v51
    v_pk_fma_f32 v[136:137], v[48:49], v[48:49], v[136:137]
    v_pk_fma_f32 v[140:141], v[112:113], v[112:113], v[140:141]
    v_pk_fma_f32 v[138:139], v[50:51], v[50:51], v[138:139]
    v_pk_fma_f32 v[142:143], v[114:115], v[114:115], v[142:143]
    s_waitcnt vmcnt(4)
    v_lshlrev_b32 v116, 16, v52
    v_and_b32 v52, s12, v52
    v_lshlrev_b32 v117, 16, v53
    v_and_b32 v53, s12, v53
    v_lshlrev_b32 v118, 16, v54
    v_and_b32 v54, s12, v54
    v_lshlrev_b32 v119, 16, v55
    v_and_b32_e64 v55, s12, v55
    v_pk_fma_f32 v[136:137], v[52:53], v[52:53], v[136:137]
    v_pk_fma_f32 v[140:141], v[116:117], v[116:117], v[140:141]
    v_pk_fma_f32 v[138:139], v[54:55], v[54:55], v[138:139]
    v_pk_fma_f32 v[142:143], v[118:119], v[118:119], v[142:143]
    s_waitcnt vmcnt(3)
    v_lshlrev_b32 v120, 16, v56
    v_and_b32 v56, s12, v56
    v_lshlrev_b32 v121, 16, v57
    v_and_b32 v57, s12, v57
    v_lshlrev_b32 v122, 16, v58
    v_and_b32 v58, s12, v58
    v_lshlrev_b32 v123, 16, v59
    v_and_b32_e64 v59, s12, v59
    v_pk_fma_f32 v[136:137], v[56:57], v[56:57], v[136:137]
    v_pk_fma_f32 v[140:141], v[120:121], v[120:121], v[140:141]
    v_pk_fma_f32 v[138:139], v[58:59], v[58:59], v[138:139]
    v_pk_fma_f32 v[142:143], v[122:123], v[122:123], v[142:143]
    s_waitcnt vmcnt(2)
    v_lshlrev_b32 v124, 16, v60
    v_and_b32 v60, s12, v60
    v_lshlrev_b32 v125, 16, v61
    v_and_b32 v61, s12, v61
    v_lshlrev_b32 v126, 16, v62
    v_and_b32 v62, s12, v62
    v_lshlrev_b32 v127, 16, v63
    v_and_b32_e64 v63, s12, v63
    v_pk_fma_f32 v[136:137], v[60:61], v[60:61], v[136:137]
    v_pk_fma_f32 v[140:141], v[124:125], v[124:125], v[140:141]
    v_pk_fma_f32 v[138:139], v[62:63], v[62:63], v[138:139]
    v_pk_fma_f32 v[142:143], v[126:127], v[126:127], v[142:143]
    s_waitcnt vmcnt(1)
    v_lshlrev_b32 v128, 16, v64
    v_and_b32 v64, s12, v64
    v_lshlrev_b32 v129, 16, v65
    v_and_b32 v65, s12, v65
    v_lshlrev_b32 v130, 16, v66
    v_and_b32 v66, s12, v66
    v_lshlrev_b32 v131, 16, v67
    v_and_b32_e64 v67, s12, v67
    v_pk_fma_f32 v[136:137], v[64:65], v[64:65], v[136:137]
    v_pk_fma_f32 v[140:141], v[128:129], v[128:129], v[140:141]
    v_pk_fma_f32 v[138:139], v[66:67], v[66:67], v[138:139]
    v_pk_fma_f32 v[142:143], v[130:131], v[130:131], v[142:143]
    s_waitcnt vmcnt(0)
    v_lshlrev_b32 v132, 16, v68
    v_and_b32 v68, s12, v68
    v_lshlrev_b32 v133, 16, v69
    v_and_b32 v69, s12, v69
    v_lshlrev_b32 v134, 16, v70
    v_and_b32 v70, s12, v70
    v_lshlrev_b32 v135, 16, v71
    v_and_b32_e64 v71, s12, v71
    v_pk_fma_f32 v[136:137], v[68:69], v[68:69], v[136:137]
    v_pk_fma_f32 v[140:141], v[132:133], v[132:133], v[140:141]
    v_pk_fma_f32 v[138:139], v[70:71], v[70:71], v[138:139]
    v_pk_fma_f32 v[142:143], v[134:135], v[134:135], v[142:143]
    v_sqrt_f32 v136, v136
    v_sqrt_f32 v137, v137
    v_sqrt_f32 v140, v140
    v_sqrt_f32 v141, v141
    v_sqrt_f32 v138, v138
    v_sqrt_f32 v139, v139
    v_sqrt_f32 v142, v142
    v_sqrt_f32 v143, v143
    v_pk_add_f32 v[160:161], v[136:137], v[140:141]
    v_pk_add_f32 v[162:163], v[138:139], v[142:143]
    v_pk_add_f32 v[160:161], v[160:161], v[162:163]
    v_add_f32_e64 v160, v160, v161
    v_pk_mul_f32 v[144:145], v[144:145], v[136:137]
    v_pk_mul_f32 v[146:147], v[146:147], v[138:139]
    v_add_f32_dpp v160, v160, v160 quad_perm:[1,0,3,2] row_mask:0xf bank_mask:0xf
    v_pk_mul_f32 v[148:149], v[148:149], v[140:141]
    v_pk_mul_f32 v[150:151], v[150:151], v[142:143]
    v_add_f32_dpp v160, v160, v160 quad_perm:[2,3,0,1] row_mask:0xf bank_mask:0xf
    s_nop 0
    s_nop 0
    v_add_f32_dpp v160, v160, v160 row_half_mirror row_mask:0xf bank_mask:0xf
    s_nop 0
    s_nop 0
    v_add_f32_dpp v160, v160, v160 row_mirror row_mask:0xf bank_mask:0xf
    s_nop 0
    s_nop 0
    v_add_f32_dpp v160, v160, v160 row_bcast:15 row_mask:0xa bank_mask:0xf
    s_nop 0
    s_nop 0
    v_add_f32_dpp v160, v160, v160 row_bcast:31 row_mask:0xc bank_mask:0xf
    v_fma_f32 v160, v160, v4, v5
    v_rcp_f32 v160, v160
    s_nop 0
    v_readlane_b32 s14, v160, 63
    s_nop 0
    s_nop 0
    v_pk_fma_f32 v[144:145], v[144:145], s[14:15], 1.0 op_sel_hi:[1,0,0]
    v_pk_fma_f32 v[148:149], v[148:149], s[14:15], 1.0 op_sel_hi:[1,0,0]
    v_pk_fma_f32 v[146:147], v[146:147], s[14:15], 1.0 op_sel_hi:[1,0,0]
    v_pk_fma_f32 v[150:151], v[150:151], s[14:15], 1.0 op_sel_hi:[1,0,0]
    v_pk_fma_f32 v[8:9], v[8:9], v[144:145], v[152:153]
    v_pk_fma_f32 v[72:73], v[72:73], v[148:149], v[156:157]
    v_pk_fma_f32 v[10:11], v[10:11], v[146:147], v[154:155]
    v_pk_fma_f32 v[74:75], v[74:75], v[150:151], v[158:159]
    v_cvt_pk_bf16_f32 v8, v72, v8
    v_cvt_pk_bf16_f32 v9, v73, v9
    v_cvt_pk_bf16_f32 v10, v74, v10
    v_cvt_pk_bf16_f32 v11, v75, v11
    global_store_dwordx4 v168, v[8:11], s[10:11] offset:0 nt
    v_pk_fma_f32 v[12:13], v[12:13], v[144:145], v[152:153]
    v_pk_fma_f32 v[76:77], v[76:77], v[148:149], v[156:157]
    v_pk_fma_f32 v[14:15], v[14:15], v[146:147], v[154:155]
    v_pk_fma_f32 v[78:79], v[78:79], v[150:151], v[158:159]
    v_cvt_pk_bf16_f32 v12, v76, v12
    v_cvt_pk_bf16_f32 v13, v77, v13
    v_cvt_pk_bf16_f32 v14, v78, v14
    v_cvt_pk_bf16_f32 v15, v79, v15
    global_store_dwordx4 v168, v[12:15], s[10:11] offset:1024 nt
    v_pk_fma_f32 v[16:17], v[16:17], v[144:145], v[152:153]
    v_pk_fma_f32 v[80:81], v[80:81], v[148:149], v[156:157]
    v_pk_fma_f32 v[18:19], v[18:19], v[146:147], v[154:155]
    v_pk_fma_f32 v[82:83], v[82:83], v[150:151], v[158:159]
    v_cvt_pk_bf16_f32 v16, v80, v16
    v_cvt_pk_bf16_f32 v17, v81, v17
    v_cvt_pk_bf16_f32 v18, v82, v18
    v_cvt_pk_bf16_f32 v19, v83, v19
    global_store_dwordx4 v168, v[16:19], s[10:11] offset:2048 nt
    v_pk_fma_f32 v[20:21], v[20:21], v[144:145], v[152:153]
    v_pk_fma_f32 v[84:85], v[84:85], v[148:149], v[156:157]
    v_pk_fma_f32 v[22:23], v[22:23], v[146:147], v[154:155]
    v_pk_fma_f32 v[86:87], v[86:87], v[150:151], v[158:159]
    v_cvt_pk_bf16_f32 v20, v84, v20
    v_cvt_pk_bf16_f32 v21, v85, v21
    v_cvt_pk_bf16_f32 v22, v86, v22
    v_cvt_pk_bf16_f32 v23, v87, v23
    global_store_dwordx4 v168, v[20:23], s[10:11] offset:3072 nt
    v_pk_fma_f32 v[24:25], v[24:25], v[144:145], v[152:153]
    v_pk_fma_f32 v[88:89], v[88:89], v[148:149], v[156:157]
    v_pk_fma_f32 v[26:27], v[26:27], v[146:147], v[154:155]
    v_pk_fma_f32 v[90:91], v[90:91], v[150:151], v[158:159]
    v_cvt_pk_bf16_f32 v24, v88, v24
    v_cvt_pk_bf16_f32 v25, v89, v25
    v_cvt_pk_bf16_f32 v26, v90, v26
    v_cvt_pk_bf16_f32 v27, v91, v27
    global_store_dwordx4 v169, v[24:27], s[10:11] offset:0 nt
    v_pk_fma_f32 v[28:29], v[28:29], v[144:145], v[152:153]
    v_pk_fma_f32 v[92:93], v[92:93], v[148:149], v[156:157]
    v_pk_fma_f32 v[30:31], v[30:31], v[146:147], v[154:155]
    v_pk_fma_f32 v[94:95], v[94:95], v[150:151], v[158:159]
    v_cvt_pk_bf16_f32 v28, v92, v28
H2:
    s_cbranch_scc1 Hback
    s_nop 0
    v_cvt_pk_bf16_f32 v29, v93, v29
    v_cvt_pk_bf16_f32 v30, v94, v30
    v_cvt_pk_bf16_f32 v31, v95, v31
    global_store_dwordx4 v169, v[28:31], s[10:11] offset:1024 nt
    v_pk_fma_f32 v[32:33], v[32:33], v[144:145], v[152:153]
    v_pk_fma_f32 v[96:97], v[96:97], v[148:149], v[156:157]
    v_pk_fma_f32 v[34:35], v[34:35], v[146:147], v[154:155]
    v_pk_fma_f32 v[98:99], v[98:99], v[150:151], v[158:159]
    v_cvt_pk_bf16_f32 v32, v96, v32
    v_cvt_pk_bf16_f32 v33, v97, v33
    v_cvt_pk_bf16_f32 v34, v98, v34
    v_cvt_pk_bf16_f32 v35, v99, v35
    global_store_dwordx4 v169, v[32:35], s[10:11] offset:2048 nt
    v_pk_fma_f32 v[36:37], v[36:37], v[144:145], v[152:153]
    v_pk_fma_f32 v[100:101], v[100:101], v[148:149], v[156:157]
    v_pk_fma_f32 v[38:39], v[38:39], v[146:147], v[154:155]
    v_pk_fma_f32 v[102:103], v[102:103], v[150:151], v[158:159]
    v_cvt_pk_bf16_f32 v36, v100, v36
    v_cvt_pk_bf16_f32 v37, v101, v37
    v_cvt_pk_bf16_f32 v38, v102, v38
    v_cvt_pk_bf16_f32 v39, v103, v39
    global_store_dwordx4 v169, v[36:39], s[10:11] offset:3072 nt
    v_pk_fma_f32 v[40:41], v[40:41], v[144:145], v[152:153]
    v_pk_fma_f32 v[104:105], v[104:105], v[148:149], v[156:157]
    v_pk_fma_f32 v[42:43], v[42:43], v[146:147], v[154:155]
    v_pk_fma_f32 v[106:107], v[106:107], v[150:151], v[158:159]
    v_cvt_pk_bf16_f32 v40, v104, v40
    v_cvt_pk_bf16_f32 v41, v105, v41
    v_cvt_pk_bf16_f32 v42, v106, v42
    v_cvt_pk_bf16_f32 v43, v107, v43
    global_store_dwordx4 v170, v[40:43], s[10:11] offset:0 nt
    v_pk_fma_f32 v[44:45], v[44:45], v[144:145], v[152:153]
    v_pk_fma_f32 v[108:109], v[108:109], v[148:149], v[156:157]
    v_pk_fma_f32 v[46:47], v[46:47], v[146:147], v[154:155]
    v_pk_fma_f32 v[110:111], v[110:111], v[150:151], v[158:159]
    v_cvt_pk_bf16_f32 v44, v108, v44
    v_cvt_pk_bf16_f32 v45, v109, v45
    v_cvt_pk_bf16_f32 v46, v110, v46
    v_cvt_pk_bf16_f32 v47, v111, v47
    global_store_dwordx4 v170, v[44:47], s[10:11] offset:1024 nt
    v_pk_fma_f32 v[48:49], v[48:49], v[144:145], v[152:153]
    v_pk_fma_f32 v[112:113], v[112:113], v[148:149], v[156:157]
    v_pk_fma_f32 v[50:51], v[50:51], v[146:147], v[154:155]
    v_pk_fma_f32 v[114:115], v[114:115], v[150:151], v[158:159]
    v_cvt_pk_bf16_f32 v48, v112, v48
    v_cvt_pk_bf16_f32 v49, v113, v49
    v_cvt_pk_bf16_f32 v50, v114, v50
    v_cvt_pk_bf16_f32 v51, v115, v51
    global_store_dwordx4 v170, v[48:51], s[10:11] offset:2048 nt
    v_pk_fma_f32 v[52:53], v[52:53], v[144:145], v[152:153]
    v_pk_fma_f32 v[116:117], v[116:117], v[148:149], v[156:157]
    v_pk_fma_f32 v[54:55], v[54:55], v[146:147], v[154:155]
    v_pk_fma_f32 v[118:119], v[118:119], v[150:151], v[158:159]
    v_cvt_pk_bf16_f32 v52, v116, v52
    v_cvt_pk_bf16_f32 v53, v117, v53
    v_cvt_pk_bf16_f32 v54, v118, v54
    v_cvt_pk_bf16_f32 v55, v119, v55
    global_store_dwordx4 v170, v[52:55], s[10:11] offset:3072 nt
    v_pk_fma_f32 v[56:57], v[56:57], v[144:145], v[152:153]
    v_pk_fma_f32 v[120:121], v[120:121], v[148:149], v[156:157]
    v_pk_fma_f32 v[58:59], v[58:59], v[146:147], v[154:155]
    v_pk_fma_f32 v[122:123], v[122:123], v[150:151], v[158:159]
    v_cvt_pk_bf16_f32 v56, v120, v56
    v_cvt_pk_bf16_f32 v57, v121, v57
    v_cvt_pk_bf16_f32 v58, v122, v58
    v_cvt_pk_bf16_f32 v59, v123, v59
    global_store_dwordx4 v171, v[56:59], s[10:11] offset:0 nt
    v_pk_fma_f32 v[60:61], v[60:61], v[144:145], v[152:153]
    v_pk_fma_f32 v[124:125], v[124:125], v[148:149], v[156:157]
    v_pk_fma_f32 v[62:63], v[62:63], v[146:147], v[154:155]
    v_pk_fma_f32 v[126:127], v[126:127], v[150:151], v[158:159]
    v_cvt_pk_bf16_f32 v60, v124, v60
    v_cvt_pk_bf16_f32 v61, v125, v61
    v_cvt_pk_bf16_f32 v62, v126, v62
    v_cvt_pk_bf16_f32 v63, v127, v63
    global_store_dwordx4 v171, v[60:63], s[10:11] offset:1024 nt
    v_pk_fma_f32 v[64:65], v[64:65], v[144:145], v[152:153]
    v_pk_fma_f32 v[128:129], v[128:129], v[148:149], v[156:157]
    v_pk_fma_f32 v[66:67], v[66:67], v[146:147], v[154:155]
    v_pk_fma_f32 v[130:131], v[130:131], v[150:151], v[158:159]
    v_cvt_pk_bf16_f32 v64, v128, v64
    v_cvt_pk_bf16_f32 v65, v129, v65
    v_cvt_pk_bf16_f32 v66, v130, v66
    v_cvt_pk_bf16_f32 v67, v131, v67
    global_store_dwordx4 v171, v[64:67], s[10:11] offset:2048 nt
    v_pk_fma_f32 v[68:69], v[68:69], v[144:145], v[152:153]
    v_pk_fma_f32 v[132:133], v[132:133], v[148:149], v[156:157]
    v_pk_fma_f32 v[70:71], v[70:71], v[146:147], v[154:155]
    v_pk_fma_f32 v[134:135], v[134:135], v[150:151], v[158:159]
    v_cvt_pk_bf16_f32 v68, v132, v68
    v_cvt_pk_bf16_f32 v69, v133, v69
    v_cvt_pk_bf16_f32 v70, v134, v70
    v_cvt_pk_bf16_f32 v71, v135, v71
    global_store_dwordx4 v171, v[68:71], s[10:11] offset:3072 nt
L_done:
    s_endpgm
.section .rodata,"a"
.p2align 6
.amdhsa_kernel standalone__grn__sampling_kernel
  .amdhsa_next_free_vgpr 172
  .amdhsa_next_free_sgpr 16
  .amdhsa_accum_offset 172
  .amdhsa_group_segment_fixed_size 0
  .amdhsa_kernarg_size 48
  .amdhsa_user_sgpr_count 2
  .amdhsa_user_sgpr_kernarg_segment_ptr 1
  .amdhsa_system_sgpr_workgroup_id_x 1
  .amdhsa_float_denorm_mode_32 3
.end_amdhsa_kernel
```
